```python
import torch

def _softmax(x, axis=-1):
    return torch.softmax(x, dim=axis)

def _gelu(x):
    return torch.nn.functional.gelu(x, approximate='tanh')

def _silu(x):
    return torch.nn.functional.silu(x)

def _sigmoid(x):
    return torch.sigmoid(x)

def _layernorm(x, axis=-1, eps=1e-05):
    m = x.mean(dim=axis, keepdim=True)
    v = x.var(dim=axis, keepdim=True, unbiased=False)
    return (x - m) / torch.sqrt(v + eps)

def _scatter_add(tgt, idx, src, axis=0):
    return tgt.clone().index_add_(axis, idx, src)

def _segment_sum(src, seg, n):
    out = torch.zeros((n,) + src.shape[1:], dtype=src.dtype)
    return out.index_add_(0, seg, src)

def _pad(x, pw):
    flat = tuple((v for pair in reversed(pw) for v in pair))
    return torch.nn.functional.pad(x, flat)
kernel_name = 'standalone__tree_speculative_verify_tree_attention_over_candidate_token_tree__decode'

def setup_inputs():

    _w = lambda a: (lambda t: t.to(torch.bfloat16) if t.is_floating_point() else t)(torch.as_tensor(a))
    B, Hq, Hkv, T, C, D = (2, 32, 4, 1, 32768, 128)
    tree_mask = torch.zeros((B, T, T), dtype=float)
    for b in range(B):
        parent = torch.zeros(T, dtype=torch.int64)
        for i in range(1, T):
            parent[i] = int(torch.randint(0, i, (1,)).item())
        for i in range(T):
            j = i
            tree_mask[b, i, j] = 1.0
            while j > 0:
                j = parent[j]
                tree_mask[b, i, j] = 1.0
    return {'q': _w((lambda *s: torch.randn(*s, dtype=torch.bfloat16) * 0.8)(B, Hq, T, D)), 'k_cache': _w((lambda *s: torch.randn(*s, dtype=torch.bfloat16) * 0.8)(B, Hkv, C, D)), 'v_cache': _w((lambda *s: torch.randn(*s, dtype=torch.bfloat16) * 0.05)(B, Hkv, C, D)), 'k_tree': _w((lambda *s: torch.randn(*s, dtype=torch.bfloat16) * 0.8)(B, Hkv, T, D)), 'v_tree': _w((lambda *s: torch.randn(*s, dtype=torch.bfloat16) * 0.05)(B, Hkv, T, D)), 'tree_mask': _w(tree_mask)}

def reference(q, k_cache, v_cache, k_tree, v_tree, tree_mask):
    B, Hq, T, D = q.shape
    Hkv, C = (k_cache.shape[1], k_cache.shape[2])
    rep = Hq // Hkv
    kc = (lambda x, n, axis: torch.repeat_interleave(x, n, dim=axis))(k_cache, rep, axis=1)
    vc = (lambda x, n, axis: torch.repeat_interleave(x, n, dim=axis))(v_cache, rep, axis=1)
    kt = (lambda x, n, axis: torch.repeat_interleave(x, n, dim=axis))(k_tree, rep, axis=1)
    vt = (lambda x, n, axis: torch.repeat_interleave(x, n, dim=axis))(v_tree, rep, axis=1)
    k = torch.concatenate([kc, kt], axis=2)
    v = torch.concatenate([vc, vt], axis=2)
    scale = D ** (-0.5)
    scores = torch.einsum('bhqd,bhkd->bhqk', q, k) * scale
    ctx_mask = torch.ones((B, 1, T, C), dtype=scores.dtype)
    tm = tree_mask[:, None, :, :].clone()
    full_mask = torch.concatenate([ctx_mask, tm], axis=-1)
    scores = scores + (1.0 - full_mask) * -1000000000.0
    p = _softmax(scores, axis=-1)
    return torch.einsum('bhqk,bhkd->bhqd', p, v)
```

```asm
; @launch grid=(256,1,1) block=(256,1,1) lds=70912
.amdgcn_target "amdgcn-amd-amdhsa--gfx950"
.text
.globl standalone__tree_speculative_verify_tree_attention_over_candidate_token_tree__decode_kernel
.p2align 8
.type standalone__tree_speculative_verify_tree_attention_over_candidate_token_tree__decode_kernel,@function
standalone__tree_speculative_verify_tree_attention_over_candidate_token_tree__decode_kernel:
    s_cmp_ge_u32 s2, 256
    s_cbranch_scc1 L_end
    s_load_dwordx16 s[4:19], s[0:1], 0
    s_load_dwordx2 s[20:21], s[0:1], 64
    s_memrealtime s[54:55]
    v_lshrrev_b32 v4, 6, v0
    v_and_b32 v1, 63, v0
    v_readfirstlane_b32 s22, v4
    v_lshrrev_b32 v2, 4, v1
    v_and_b32 v3, 15, v0
    s_and_b32 s60, s2, 7
    s_lshr_b32 s61, s2, 3
    v_lshlrev_b32 v5, 8, v2
    v_xor_b32 v6, v3, v2
    v_lshl_add_u32 v12, v6, 4, v5
    v_xor_b32 v7, 4, v6
    v_lshl_add_u32 v13, v7, 4, v5
    v_xor_b32 v7, 8, v6
    v_lshl_add_u32 v14, v7, 4, v5
    v_xor_b32 v7, 12, v6
    v_lshl_add_u32 v15, v7, 4, v5
    v_and_b32 v8, 7, v3
    v_lshlrev_b32 v8, 8, v8
    v_lshl_add_u32 v8, v2, 4, v8
    s_lshl_b32 s71, s60, 11
    s_mul_i32 s23, s22, 12288
    s_lshl_b32 s67, s61, 18
    s_lshl_b32 s62, s60, 23
    s_add_u32 s62, s62, s67
    s_lshl_b32 s67, s22, 12
    s_add_u32 s62, s62, s67
    s_mov_b32 s26, 0x4000000
    s_mov_b32 s27, 0x00020000
    s_mov_b32 m0, s23
    s_waitcnt lgkmcnt(0)
    s_mov_b32 s24, s6
    s_and_b32 s25, s7, 0xffff
    s_mov_b32 s32, s4
    s_and_b32 s33, s5, 0xffff
    s_mov_b32 s34, 16384
    s_mov_b32 s35, 0x00020000
    buffer_load_dwordx4 v[52:55], v8, s[32:35], s71 offen offset:0
    buffer_load_dwordx4 v[56:59], v8, s[32:35], s71 offen offset:64
    buffer_load_dwordx4 v[60:63], v8, s[32:35], s71 offen offset:128
    buffer_load_dwordx4 v[64:67], v8, s[32:35], s71 offen offset:192
    buffer_load_dwordx4 v12, s[24:27], s62 offen offset:0 nt lds
    buffer_load_dwordx4 v13, s[24:27], s62 offen offset:1024 nt lds
    buffer_load_dwordx4 v14, s[24:27], s62 offen offset:2048 nt lds
    buffer_load_dwordx4 v15, s[24:27], s62 offen offset:3072 nt lds
    s_add_u32 m0, s23, 4096
    s_add_u32 s63, s62, 16384
    buffer_load_dwordx4 v12, s[24:27], s63 offen offset:0 nt lds
    buffer_load_dwordx4 v13, s[24:27], s63 offen offset:1024 nt lds
    buffer_load_dwordx4 v14, s[24:27], s63 offen offset:2048 nt lds
    buffer_load_dwordx4 v15, s[24:27], s63 offen offset:3072 nt lds
    s_load_dword s65, s[14:15], 0
    s_mov_b32 s44, s18
    s_and_b32 s45, s19, 0xffff
    s_mov_b32 s46, 256
    s_mov_b32 s47, 0x00020000
    s_getreg_b32 s86, hwreg(HW_REG_XCC_ID, 0, 4)
    s_lshl_b32 s87, s60, 4
    s_add_u32 s86, s86, 1
    s_or_b32 s67, s61, s22
    s_cbranch_scc1 L_nonon
    v_mov_b32 v32, s54
    v_mov_b32 v33, s55
    v_mov_b32 v34, s86
    v_mov_b32 v35, 0
    s_mov_b64 exec, 1
    buffer_store_dwordx4 v[32:35], off, s[44:47], s87 sc1
    s_mov_b64 exec, -1
L_nonon:
    v_lshlrev_b32 v6, 1, v2
    v_xor_b32 v6, v6, v3
    v_lshl_add_u32 v16, v6, 4, v5
    v_xor_b32 v6, 8, v6
    v_lshl_add_u32 v17, v6, 4, v5
    s_mov_b32 s28, s8
    s_and_b32 s29, s9, 0xffff
    s_mov_b32 s30, 67108864
    s_mov_b32 s31, 0x00020000
    s_mov_b32 s36, s20
    s_and_b32 s37, s21, 0xffff
    s_mov_b32 s38, 268435456
    s_mov_b32 s39, 0x00020000
    s_mov_b32 s40, s16
    s_and_b32 s41, s17, 0xffff
    s_mov_b32 s42, 16384
    s_mov_b32 s43, 0x00020000
    s_mov_b32 s48, s10
    s_and_b32 s49, s11, 0xffff
    s_mov_b32 s50, 2048
    s_mov_b32 s51, 0x00020000
    s_mov_b32 s32, s12
    s_and_b32 s33, s13, 0xffff
    s_mov_b32 s34, 2048
    s_mov_b32 s35, 0x00020000
    v_and_b32 v10, 7, v3
    v_lshlrev_b32 v10, 14, v10
    v_lshrrev_b32 v11, 3, v3
    v_lshl_add_u32 v11, v11, 2, v2
    v_lshl_add_u32 v36, v11, 4, v10
    s_lshl_b32 s67, s22, 12
    v_add_u32 v36, s67, v36
    s_lshl_b32 s68, s60, 17
    s_lshl_b32 s69, s61, 7
    s_add_u32 s68, s68, s69
    v_and_b32 v11, 1, v3
    v_lshlrev_b32 v11, 6, v11
    v_lshl_add_u32 v38, v2, 4, v11
    s_lshl_b32 s69, s60, 5
    s_add_u32 s69, s69, s61
    s_lshl_b32 s69, s69, 2
    s_add_u32 s69, s69, s22
    s_lshl_b32 s69, s69, 7
    s_add_u32 s69, s69, 1048576
    v_or_b32 v6, 0, v2
    v_xor_b32 v6, v6, v3
    v_lshlrev_b32 v6, 4, v6
    v_lshl_add_u32 v6, v3, 8, v6
    v_add_u32 v18, s23, v6
    v_or_b32 v6, 4, v2
    v_xor_b32 v6, v6, v3
    v_lshlrev_b32 v6, 4, v6
    v_lshl_add_u32 v6, v3, 8, v6
    v_add_u32 v19, s23, v6
    v_or_b32 v6, 8, v2
    v_xor_b32 v6, v6, v3
    v_lshlrev_b32 v6, 4, v6
    v_lshl_add_u32 v6, v3, 8, v6
    v_add_u32 v20, s23, v6
    v_or_b32 v6, 12, v2
    v_xor_b32 v6, v6, v3
    v_lshlrev_b32 v6, 4, v6
    v_lshl_add_u32 v6, v3, 8, v6
    v_add_u32 v21, s23, v6
    v_lshrrev_b32 v6, 2, v3
    v_lshl_add_u32 v6, v2, 2, v6
    v_and_b32 v7, 3, v3
    v_lshlrev_b32 v7, 3, v7
    v_lshl_add_u32 v7, v6, 8, v7
    v_add_u32 v7, s23, v7
    v_and_b32 v6, 7, v6
    v_xor_b32 v8, 0, v6
    v_lshl_add_u32 v22, v8, 5, v7
    v_xor_b32 v8, 1, v6
    v_lshl_add_u32 v23, v8, 5, v7
    v_xor_b32 v8, 2, v6
    v_lshl_add_u32 v24, v8, 5, v7
    v_xor_b32 v8, 3, v6
    v_lshl_add_u32 v25, v8, 5, v7
    v_xor_b32 v8, 4, v6
    v_lshl_add_u32 v26, v8, 5, v7
    v_xor_b32 v8, 5, v6
    v_lshl_add_u32 v27, v8, 5, v7
    v_xor_b32 v8, 6, v6
    v_lshl_add_u32 v28, v8, 5, v7
    v_xor_b32 v8, 7, v6
    v_lshl_add_u32 v29, v8, 5, v7
    s_lshl_b32 s67, s22, 1
    v_subrev_u32 v7, s23, v7
    v_xor_b32 v8, s67, v6
    v_lshl_add_u32 v42, v8, 5, v7
    v_xor_b32 v8, 1, v8
    v_lshl_add_u32 v43, v8, 5, v7
    v_and_b32 v6, 7, v3
    v_mul_u32_u24 v39, 528, v6
    v_lshl_add_u32 v39, v2, 4, v39
    v_add_u32 v39, 49920, v39
    s_lshl_b32 s67, s22, 7
    v_add_u32 v40, s67, v39
    s_mul_i32 s67, s22, 4224
    v_add_u32 v39, s67, v39
    v_lshlrev_b32 v41, 4, v1
    v_add_u32 v41, 66816, v41
    v_lshlrev_b32 v44, 4, v3
    v_add_u32 v44, 49152, v44
    s_lshl_b32 s67, s22, 2
    s_add_u32 s67, s67, 49152
    v_lshlrev_b32 v45, 4, v3
    v_add_u32 v45, s67, v45
    v_lshlrev_b32 v47, 4, v1
    v_lshrrev_b32 v10, 3, v1
    v_and_b32 v11, 3, v1
    v_lshl_add_u32 v10, v11, 3, v10
    v_lshlrev_b32 v48, 9, v10
    v_and_b32 v11, 7, v1
    v_lshlrev_b32 v49, 3, v11
    v_and_b32 v11, 1, v2
    v_lshl_add_u32 v49, v11, 2, v49
    v_and_b32 v11, 2, v2
    v_add_u32 v49, v11, v49
    s_lshl_b32 s56, s60, 17
    s_lshl_b32 s57, s61, 12
    s_add_u32 s56, s56, s57
    s_lshl_b32 s57, s60, 14
    s_lshl_b32 s58, s61, 4
    s_add_u32 s57, s57, s58
    s_add_u32 s57, s57, 1048576
    s_lshl_b32 s58, s60, 11
    s_lshl_b32 s67, s61, 6
    s_add_u32 s58, s58, s67
    buffer_load_dword v9, off, s[28:31], s62
    s_mov_b32 s66, 1040356334
    v_mov_b32 v37, 0xff800000
    s_mov_b32 s59, 0
    s_waitcnt vmcnt(5)
    ds_read_b128 v[68:71], v18 offset:0
    ds_read_b128 v[72:75], v19 offset:0
    ds_read_b128 v[76:79], v20 offset:0
    ds_read_b128 v[80:83], v21 offset:0
    s_add_u32 m0, s23, 8192
    s_add_u32 s63, s62, 32768
    buffer_load_dwordx4 v12, s[24:27], s63 offen offset:0 nt lds
    buffer_load_dwordx4 v13, s[24:27], s63 offen offset:1024 nt lds
    buffer_load_dwordx4 v14, s[24:27], s63 offen offset:2048 nt lds
    buffer_load_dwordx4 v15, s[24:27], s63 offen offset:3072 nt lds
    s_waitcnt lgkmcnt(0)
    v_mfma_f32_16x16x32_bf16 v[140:143], v[68:71], v[52:55], 0
    v_mfma_f32_16x16x32_bf16 v[140:143], v[72:75], v[56:59], v[140:143]
    v_mfma_f32_16x16x32_bf16 v[140:143], v[76:79], v[60:63], v[140:143]
    v_mfma_f32_16x16x32_bf16 v[140:143], v[80:83], v[64:67], v[140:143]
    s_waitcnt vmcnt(5)
    ds_read_b128 v[68:71], v18 offset:4096
    ds_read_b128 v[72:75], v19 offset:4096
    ds_read_b128 v[76:79], v20 offset:4096
    ds_read_b128 v[80:83], v21 offset:4096
    s_add_u32 m0, s23, 0
    s_add_u32 s63, s62, 49152
    buffer_load_dwordx4 v12, s[24:27], s63 offen offset:0 nt lds
    buffer_load_dwordx4 v13, s[24:27], s63 offen offset:1024 nt lds
    buffer_load_dwordx4 v14, s[24:27], s63 offen offset:2048 nt lds
    buffer_load_dwordx4 v15, s[24:27], s63 offen offset:3072 nt lds
    v_max3_f32 v37, v37, v140, v141
    v_max3_f32 v37, v37, v142, v143
    s_waitcnt lgkmcnt(0)
    v_mfma_f32_16x16x32_bf16 v[144:147], v[68:71], v[52:55], 0
    v_mfma_f32_16x16x32_bf16 v[144:147], v[72:75], v[56:59], v[144:147]
    v_mfma_f32_16x16x32_bf16 v[144:147], v[76:79], v[60:63], v[144:147]
    v_mfma_f32_16x16x32_bf16 v[144:147], v[80:83], v[64:67], v[144:147]
    s_waitcnt vmcnt(4)
    ds_read_b128 v[68:71], v18 offset:8192
    ds_read_b128 v[72:75], v19 offset:8192
    ds_read_b128 v[76:79], v20 offset:8192
    ds_read_b128 v[80:83], v21 offset:8192
    s_add_u32 m0, s23, 4096
    s_add_u32 s63, s62, 65536
    buffer_load_dwordx4 v12, s[24:27], s63 offen offset:0 nt lds
    buffer_load_dwordx4 v13, s[24:27], s63 offen offset:1024 nt lds
    buffer_load_dwordx4 v14, s[24:27], s63 offen offset:2048 nt lds
    buffer_load_dwordx4 v15, s[24:27], s63 offen offset:3072 nt lds
    v_max3_f32 v37, v37, v144, v145
    v_max3_f32 v37, v37, v146, v147
    s_waitcnt lgkmcnt(0)
    v_mfma_f32_16x16x32_bf16 v[148:151], v[68:71], v[52:55], 0
    v_mfma_f32_16x16x32_bf16 v[148:151], v[72:75], v[56:59], v[148:151]
    v_mfma_f32_16x16x32_bf16 v[148:151], v[76:79], v[60:63], v[148:151]
    v_mfma_f32_16x16x32_bf16 v[148:151], v[80:83], v[64:67], v[148:151]
    s_waitcnt vmcnt(4)
    ds_read_b128 v[68:71], v18 offset:0
    ds_read_b128 v[72:75], v19 offset:0
    ds_read_b128 v[76:79], v20 offset:0
    ds_read_b128 v[80:83], v21 offset:0
    s_add_u32 m0, s23, 8192
    s_add_u32 s63, s62, 81920
    buffer_load_dwordx4 v12, s[24:27], s63 offen offset:0 nt lds
    buffer_load_dwordx4 v13, s[24:27], s63 offen offset:1024 nt lds
    buffer_load_dwordx4 v14, s[24:27], s63 offen offset:2048 nt lds
    buffer_load_dwordx4 v15, s[24:27], s63 offen offset:3072 nt lds
    v_max3_f32 v37, v37, v148, v149
    v_max3_f32 v37, v37, v150, v151
    s_waitcnt lgkmcnt(0)
    v_mfma_f32_16x16x32_bf16 v[152:155], v[68:71], v[52:55], 0
    v_mfma_f32_16x16x32_bf16 v[152:155], v[72:75], v[56:59], v[152:155]
    v_mfma_f32_16x16x32_bf16 v[152:155], v[76:79], v[60:63], v[152:155]
    v_mfma_f32_16x16x32_bf16 v[152:155], v[80:83], v[64:67], v[152:155]
    s_waitcnt vmcnt(4)
    ds_read_b128 v[68:71], v18 offset:4096
    ds_read_b128 v[72:75], v19 offset:4096
    ds_read_b128 v[76:79], v20 offset:4096
    ds_read_b128 v[80:83], v21 offset:4096
    s_add_u32 m0, s23, 0
    s_add_u32 s63, s62, 98304
    buffer_load_dwordx4 v12, s[24:27], s63 offen offset:0 nt lds
    buffer_load_dwordx4 v13, s[24:27], s63 offen offset:1024 nt lds
    buffer_load_dwordx4 v14, s[24:27], s63 offen offset:2048 nt lds
    buffer_load_dwordx4 v15, s[24:27], s63 offen offset:3072 nt lds
    s_cmp_lg_u32 s22, 0
    s_cbranch_scc1 L_notree0
    s_lshl_b32 s67, s60, 8
    v_lshlrev_b32 v4, 2, v1
    s_mov_b32 m0, 49664
    s_and_b32 s70, s61, 3
    buffer_load_dword v4, s[48:51], s67 offen lds
    s_lshl_b32 s70, s70, 6
    s_add_u32 s67, s67, s70
    buffer_load_ushort v50, v49, s[32:35], s67 offen
L_notree0:
    v_max3_f32 v37, v37, v152, v153
    v_max3_f32 v37, v37, v154, v155
    s_waitcnt lgkmcnt(0)
    v_mfma_f32_16x16x32_bf16 v[156:159], v[68:71], v[52:55], 0
    v_mfma_f32_16x16x32_bf16 v[156:159], v[72:75], v[56:59], v[156:159]
    v_mfma_f32_16x16x32_bf16 v[156:159], v[76:79], v[60:63], v[156:159]
    v_mfma_f32_16x16x32_bf16 v[156:159], v[80:83], v[64:67], v[156:159]
    s_waitcnt vmcnt(4)
    ds_read_b128 v[68:71], v18 offset:8192
    ds_read_b128 v[72:75], v19 offset:8192
    ds_read_b128 v[76:79], v20 offset:8192
    ds_read_b128 v[80:83], v21 offset:8192
    s_add_u32 m0, s23, 4096
    s_add_u32 s63, s62, 114688
    buffer_load_dwordx4 v12, s[24:27], s63 offen offset:0 nt lds
    buffer_load_dwordx4 v13, s[24:27], s63 offen offset:1024 nt lds
    buffer_load_dwordx4 v14, s[24:27], s63 offen offset:2048 nt lds
    buffer_load_dwordx4 v15, s[24:27], s63 offen offset:3072 nt lds
    v_max3_f32 v37, v37, v156, v157
    v_max3_f32 v37, v37, v158, v159
    s_waitcnt lgkmcnt(0)
    v_mfma_f32_16x16x32_bf16 v[160:163], v[68:71], v[52:55], 0
    v_mfma_f32_16x16x32_bf16 v[160:163], v[72:75], v[56:59], v[160:163]
    v_mfma_f32_16x16x32_bf16 v[160:163], v[76:79], v[60:63], v[160:163]
    v_mfma_f32_16x16x32_bf16 v[160:163], v[80:83], v[64:67], v[160:163]
    s_waitcnt vmcnt(4)
    ds_read_b128 v[68:71], v18 offset:0
    ds_read_b128 v[72:75], v19 offset:0
    ds_read_b128 v[76:79], v20 offset:0
    ds_read_b128 v[80:83], v21 offset:0
    s_add_u32 m0, s23, 8192
    s_add_u32 s63, s62, 131072
    buffer_load_dwordx4 v12, s[24:27], s63 offen offset:0 nt lds
    buffer_load_dwordx4 v13, s[24:27], s63 offen offset:1024 nt lds
    buffer_load_dwordx4 v14, s[24:27], s63 offen offset:2048 nt lds
    buffer_load_dwordx4 v15, s[24:27], s63 offen offset:3072 nt lds
    v_max3_f32 v37, v37, v160, v161
    v_max3_f32 v37, v37, v162, v163
    s_waitcnt lgkmcnt(0)
    v_mfma_f32_16x16x32_bf16 v[164:167], v[68:71], v[52:55], 0
    v_mfma_f32_16x16x32_bf16 v[164:167], v[72:75], v[56:59], v[164:167]
    v_mfma_f32_16x16x32_bf16 v[164:167], v[76:79], v[60:63], v[164:167]
    v_mfma_f32_16x16x32_bf16 v[164:167], v[80:83], v[64:67], v[164:167]
    s_waitcnt vmcnt(4)
    ds_read_b128 v[68:71], v18 offset:4096
    ds_read_b128 v[72:75], v19 offset:4096
    ds_read_b128 v[76:79], v20 offset:4096
    ds_read_b128 v[80:83], v21 offset:4096
    s_add_u32 m0, s23, 0
    s_add_u32 s63, s62, 147456
    buffer_load_dwordx4 v12, s[24:27], s63 offen offset:0 nt lds
    buffer_load_dwordx4 v13, s[24:27], s63 offen offset:1024 nt lds
    buffer_load_dwordx4 v14, s[24:27], s63 offen offset:2048 nt lds
    buffer_load_dwordx4 v15, s[24:27], s63 offen offset:3072 nt lds
    v_max3_f32 v37, v37, v164, v165
    v_max3_f32 v37, v37, v166, v167
    s_waitcnt lgkmcnt(0)
    v_mfma_f32_16x16x32_bf16 v[168:171], v[68:71], v[52:55], 0
    v_mfma_f32_16x16x32_bf16 v[168:171], v[72:75], v[56:59], v[168:171]
    v_mfma_f32_16x16x32_bf16 v[168:171], v[76:79], v[60:63], v[168:171]
    v_mfma_f32_16x16x32_bf16 v[168:171], v[80:83], v[64:67], v[168:171]
    s_waitcnt vmcnt(4)
    ds_read_b128 v[68:71], v18 offset:8192
    ds_read_b128 v[72:75], v19 offset:8192
    ds_read_b128 v[76:79], v20 offset:8192
    ds_read_b128 v[80:83], v21 offset:8192
    s_add_u32 m0, s23, 4096
    s_add_u32 s63, s62, 163840
    buffer_load_dwordx4 v12, s[24:27], s63 offen offset:0 nt lds
    buffer_load_dwordx4 v13, s[24:27], s63 offen offset:1024 nt lds
    buffer_load_dwordx4 v14, s[24:27], s63 offen offset:2048 nt lds
    buffer_load_dwordx4 v15, s[24:27], s63 offen offset:3072 nt lds
    v_max3_f32 v37, v37, v168, v169
    v_max3_f32 v37, v37, v170, v171
    s_waitcnt lgkmcnt(0)
    v_mfma_f32_16x16x32_bf16 v[172:175], v[68:71], v[52:55], 0
    v_mfma_f32_16x16x32_bf16 v[172:175], v[72:75], v[56:59], v[172:175]
    v_mfma_f32_16x16x32_bf16 v[172:175], v[76:79], v[60:63], v[172:175]
    v_mfma_f32_16x16x32_bf16 v[172:175], v[80:83], v[64:67], v[172:175]
    s_waitcnt vmcnt(4)
    ds_read_b128 v[68:71], v18 offset:0
    ds_read_b128 v[72:75], v19 offset:0
    ds_read_b128 v[76:79], v20 offset:0
    ds_read_b128 v[80:83], v21 offset:0
    s_add_u32 m0, s23, 8192
    s_add_u32 s63, s62, 180224
    buffer_load_dwordx4 v12, s[24:27], s63 offen offset:0 nt lds
    buffer_load_dwordx4 v13, s[24:27], s63 offen offset:1024 nt lds
    buffer_load_dwordx4 v14, s[24:27], s63 offen offset:2048 nt lds
    buffer_load_dwordx4 v15, s[24:27], s63 offen offset:3072 nt lds
    v_max3_f32 v37, v37, v172, v173
    v_max3_f32 v37, v37, v174, v175
    s_waitcnt lgkmcnt(0)
    v_mfma_f32_16x16x32_bf16 v[176:179], v[68:71], v[52:55], 0
    v_mfma_f32_16x16x32_bf16 v[176:179], v[72:75], v[56:59], v[176:179]
    v_mfma_f32_16x16x32_bf16 v[176:179], v[76:79], v[60:63], v[176:179]
    v_mfma_f32_16x16x32_bf16 v[176:179], v[80:83], v[64:67], v[176:179]
    s_waitcnt vmcnt(4)
    ds_read_b128 v[68:71], v18 offset:4096
    ds_read_b128 v[72:75], v19 offset:4096
    ds_read_b128 v[76:79], v20 offset:4096
    ds_read_b128 v[80:83], v21 offset:4096
    s_add_u32 m0, s23, 0
    s_add_u32 s63, s62, 196608
    buffer_load_dwordx4 v12, s[24:27], s63 offen offset:0 nt lds
    buffer_load_dwordx4 v13, s[24:27], s63 offen offset:1024 nt lds
    buffer_load_dwordx4 v14, s[24:27], s63 offen offset:2048 nt lds
    buffer_load_dwordx4 v15, s[24:27], s63 offen offset:3072 nt lds
    v_max3_f32 v37, v37, v176, v177
    v_max3_f32 v37, v37, v178, v179
    s_waitcnt lgkmcnt(0)
    v_mfma_f32_16x16x32_bf16 v[180:183], v[68:71], v[52:55], 0
    v_mfma_f32_16x16x32_bf16 v[180:183], v[72:75], v[56:59], v[180:183]
    v_mfma_f32_16x16x32_bf16 v[180:183], v[76:79], v[60:63], v[180:183]
    v_mfma_f32_16x16x32_bf16 v[180:183], v[80:83], v[64:67], v[180:183]
    s_waitcnt vmcnt(4)
    ds_read_b128 v[68:71], v18 offset:8192
    ds_read_b128 v[72:75], v19 offset:8192
    ds_read_b128 v[76:79], v20 offset:8192
    ds_read_b128 v[80:83], v21 offset:8192
    s_add_u32 m0, s23, 4096
    s_add_u32 s63, s62, 212992
    buffer_load_dwordx4 v12, s[24:27], s63 offen offset:0 nt lds
    buffer_load_dwordx4 v13, s[24:27], s63 offen offset:1024 nt lds
    buffer_load_dwordx4 v14, s[24:27], s63 offen offset:2048 nt lds
    buffer_load_dwordx4 v15, s[24:27], s63 offen offset:3072 nt lds
    v_max3_f32 v37, v37, v180, v181
    v_max3_f32 v37, v37, v182, v183
    s_waitcnt lgkmcnt(0)
    v_mfma_f32_16x16x32_bf16 v[184:187], v[68:71], v[52:55], 0
    v_mfma_f32_16x16x32_bf16 v[184:187], v[72:75], v[56:59], v[184:187]
    v_mfma_f32_16x16x32_bf16 v[184:187], v[76:79], v[60:63], v[184:187]
    v_mfma_f32_16x16x32_bf16 v[184:187], v[80:83], v[64:67], v[184:187]
    s_waitcnt vmcnt(4)
    ds_read_b128 v[68:71], v18 offset:0
    ds_read_b128 v[72:75], v19 offset:0
    ds_read_b128 v[76:79], v20 offset:0
    ds_read_b128 v[80:83], v21 offset:0
    s_add_u32 m0, s23, 8192
    s_add_u32 s63, s62, 229376
    buffer_load_dwordx4 v12, s[24:27], s63 offen offset:0 nt lds
    buffer_load_dwordx4 v13, s[24:27], s63 offen offset:1024 nt lds
    buffer_load_dwordx4 v14, s[24:27], s63 offen offset:2048 nt lds
    buffer_load_dwordx4 v15, s[24:27], s63 offen offset:3072 nt lds
    v_max3_f32 v37, v37, v184, v185
    v_max3_f32 v37, v37, v186, v187
    s_waitcnt lgkmcnt(0)
    v_mfma_f32_16x16x32_bf16 v[188:191], v[68:71], v[52:55], 0
    v_mfma_f32_16x16x32_bf16 v[188:191], v[72:75], v[56:59], v[188:191]
    v_mfma_f32_16x16x32_bf16 v[188:191], v[76:79], v[60:63], v[188:191]
    v_mfma_f32_16x16x32_bf16 v[188:191], v[80:83], v[64:67], v[188:191]
    s_waitcnt vmcnt(4)
    ds_read_b128 v[68:71], v18 offset:4096
    ds_read_b128 v[72:75], v19 offset:4096
    ds_read_b128 v[76:79], v20 offset:4096
    ds_read_b128 v[80:83], v21 offset:4096
    s_add_u32 m0, s23, 0
    s_add_u32 s63, s62, 245760
    buffer_load_dwordx4 v12, s[24:27], s63 offen offset:0 nt lds
    buffer_load_dwordx4 v13, s[24:27], s63 offen offset:1024 nt lds
    buffer_load_dwordx4 v14, s[24:27], s63 offen offset:2048 nt lds
    buffer_load_dwordx4 v15, s[24:27], s63 offen offset:3072 nt lds
    v_max3_f32 v37, v37, v188, v189
    v_max3_f32 v37, v37, v190, v191
    s_waitcnt lgkmcnt(0)
    v_mfma_f32_16x16x32_bf16 v[192:195], v[68:71], v[52:55], 0
    v_mfma_f32_16x16x32_bf16 v[192:195], v[72:75], v[56:59], v[192:195]
    v_mfma_f32_16x16x32_bf16 v[192:195], v[76:79], v[60:63], v[192:195]
    v_mfma_f32_16x16x32_bf16 v[192:195], v[80:83], v[64:67], v[192:195]
    s_waitcnt vmcnt(4)
    ds_read_b128 v[68:71], v18 offset:8192
    ds_read_b128 v[72:75], v19 offset:8192
    ds_read_b128 v[76:79], v20 offset:8192
    ds_read_b128 v[80:83], v21 offset:8192
    s_add_u32 m0, s23, 4096
    s_add_u32 s63, s62, 0
    buffer_load_dwordx4 v16, s[28:31], s63 offen offset:0 nt lds
    buffer_load_dwordx4 v17, s[28:31], s63 offen offset:1024 nt lds
    buffer_load_dwordx4 v16, s[28:31], s63 offen offset:2048 nt lds
    buffer_load_dwordx4 v17, s[28:31], s63 offen offset:3072 nt lds
    v_max3_f32 v37, v37, v192, v193
    v_max3_f32 v37, v37, v194, v195
    s_waitcnt lgkmcnt(0)
    v_mfma_f32_16x16x32_bf16 v[196:199], v[68:71], v[52:55], 0
    v_mfma_f32_16x16x32_bf16 v[196:199], v[72:75], v[56:59], v[196:199]
    v_mfma_f32_16x16x32_bf16 v[196:199], v[76:79], v[60:63], v[196:199]
    v_mfma_f32_16x16x32_bf16 v[196:199], v[80:83], v[64:67], v[196:199]
    s_waitcnt vmcnt(4)
    ds_read_b128 v[68:71], v18 offset:0
    ds_read_b128 v[72:75], v19 offset:0
    ds_read_b128 v[76:79], v20 offset:0
    ds_read_b128 v[80:83], v21 offset:0
    s_add_u32 m0, s23, 8192
    s_add_u32 s63, s62, 16384
    buffer_load_dwordx4 v16, s[28:31], s63 offen offset:0 nt lds
    buffer_load_dwordx4 v17, s[28:31], s63 offen offset:1024 nt lds
    buffer_load_dwordx4 v16, s[28:31], s63 offen offset:2048 nt lds
    buffer_load_dwordx4 v17, s[28:31], s63 offen offset:3072 nt lds
    v_max3_f32 v37, v37, v196, v197
    v_max3_f32 v37, v37, v198, v199
    s_waitcnt lgkmcnt(0)
    v_mfma_f32_16x16x32_bf16 v[200:203], v[68:71], v[52:55], 0
    v_mfma_f32_16x16x32_bf16 v[200:203], v[72:75], v[56:59], v[200:203]
    v_mfma_f32_16x16x32_bf16 v[200:203], v[76:79], v[60:63], v[200:203]
    v_mfma_f32_16x16x32_bf16 v[200:203], v[80:83], v[64:67], v[200:203]
    v_mov_b32 v30, 0
    v_mov_b32 v31, 0
    s_nop 5
    v_max3_f32 v37, v37, v200, v201
    v_max3_f32 v37, v37, v202, v203
    v_mov_b32 v4, v37
    s_nop 1
    v_permlane16_swap_b32 v37, v4
    v_max_f32 v37, v37, v4
    v_mov_b32 v4, v37
    s_nop 1
    v_permlane32_swap_b32 v37, v4
    v_max_f32 v37, v37, v4
    v_mul_f32 v37, s66, v37
    ds_write_b32 v45, v37
    s_waitcnt vmcnt(4)
    ds_read_b64_tr_b16 v[68:69], v22 offset:4096
    ds_read_b64_tr_b16 v[72:73], v23 offset:4096
    ds_read_b64_tr_b16 v[76:77], v24 offset:4096
    ds_read_b64_tr_b16 v[80:81], v25 offset:4096
    ds_read_b64_tr_b16 v[84:85], v26 offset:4096
    ds_read_b64_tr_b16 v[88:89], v27 offset:4096
    ds_read_b64_tr_b16 v[92:93], v28 offset:4096
    ds_read_b64_tr_b16 v[96:97], v29 offset:4096
    s_add_u32 m0, s23, 0
    s_add_u32 s63, s62, 32768
    buffer_load_dwordx4 v16, s[28:31], s63 offen offset:0 nt lds
    buffer_load_dwordx4 v17, s[28:31], s63 offen offset:1024 nt lds
    buffer_load_dwordx4 v16, s[28:31], s63 offen offset:2048 nt lds
    buffer_load_dwordx4 v17, s[28:31], s63 offen offset:3072 nt lds
    v_fma_f32 v140, v140, s66, -v37
    v_fma_f32 v141, v141, s66, -v37
    v_fma_f32 v142, v142, s66, -v37
    v_fma_f32 v143, v143, s66, -v37
    v_fma_f32 v144, v144, s66, -v37
    v_fma_f32 v145, v145, s66, -v37
    v_fma_f32 v146, v146, s66, -v37
    v_fma_f32 v147, v147, s66, -v37
    v_exp_f32 v140, v140
    v_exp_f32 v141, v141
    v_exp_f32 v142, v142
    v_exp_f32 v143, v143
    v_exp_f32 v144, v144
    v_exp_f32 v145, v145
    v_exp_f32 v146, v146
    v_exp_f32 v147, v147
    s_nop 0
    v_add_f32 v30, v30, v140
    v_add_f32 v31, v31, v141
    v_cvt_pk_bf16_f32 v132, v140, v141
    v_add_f32 v30, v30, v142
    v_add_f32 v31, v31, v143
    v_cvt_pk_bf16_f32 v133, v142, v143
    v_add_f32 v30, v30, v144
    v_add_f32 v31, v31, v145
    v_cvt_pk_bf16_f32 v134, v144, v145
    v_add_f32 v30, v30, v146
    v_add_f32 v31, v31, v147
    v_cvt_pk_bf16_f32 v135, v146, v147
    s_waitcnt vmcnt(4) lgkmcnt(0)
    ds_read_b64_tr_b16 v[70:71], v22 offset:8192
    ds_read_b64_tr_b16 v[74:75], v23 offset:8192
    ds_read_b64_tr_b16 v[78:79], v24 offset:8192
    ds_read_b64_tr_b16 v[82:83], v25 offset:8192
    ds_read_b64_tr_b16 v[86:87], v26 offset:8192
    ds_read_b64_tr_b16 v[90:91], v27 offset:8192
    ds_read_b64_tr_b16 v[94:95], v28 offset:8192
    ds_read_b64_tr_b16 v[98:99], v29 offset:8192
    s_add_u32 m0, s23, 4096
    s_add_u32 s63, s62, 49152
    buffer_load_dwordx4 v16, s[28:31], s63 offen offset:0 nt lds
    buffer_load_dwordx4 v17, s[28:31], s63 offen offset:1024 nt lds
    buffer_load_dwordx4 v16, s[28:31], s63 offen offset:2048 nt lds
    buffer_load_dwordx4 v17, s[28:31], s63 offen offset:3072 nt lds
    s_waitcnt lgkmcnt(7)
    v_mfma_f32_16x16x32_bf16 v[100:103], v[68:71], v[132:135], 0
    s_waitcnt lgkmcnt(6)
    v_mfma_f32_16x16x32_bf16 v[104:107], v[72:75], v[132:135], 0
    s_waitcnt lgkmcnt(5)
    v_mfma_f32_16x16x32_bf16 v[108:111], v[76:79], v[132:135], 0
    s_waitcnt lgkmcnt(4)
    v_mfma_f32_16x16x32_bf16 v[112:115], v[80:83], v[132:135], 0
    s_waitcnt lgkmcnt(3)
    v_mfma_f32_16x16x32_bf16 v[116:119], v[84:87], v[132:135], 0
    s_waitcnt lgkmcnt(2)
    v_mfma_f32_16x16x32_bf16 v[120:123], v[88:91], v[132:135], 0
    s_waitcnt lgkmcnt(1)
    v_mfma_f32_16x16x32_bf16 v[124:127], v[92:95], v[132:135], 0
    s_waitcnt lgkmcnt(0)
    v_mfma_f32_16x16x32_bf16 v[128:131], v[96:99], v[132:135], 0
    v_fma_f32 v148, v148, s66, -v37
    v_fma_f32 v149, v149, s66, -v37
    v_fma_f32 v150, v150, s66, -v37
    v_fma_f32 v151, v151, s66, -v37
    v_fma_f32 v152, v152, s66, -v37
    v_fma_f32 v153, v153, s66, -v37
    v_fma_f32 v154, v154, s66, -v37
    v_fma_f32 v155, v155, s66, -v37
    v_exp_f32 v148, v148
    v_exp_f32 v149, v149
    v_exp_f32 v150, v150
    v_exp_f32 v151, v151
    v_exp_f32 v152, v152
    v_exp_f32 v153, v153
    v_exp_f32 v154, v154
    v_exp_f32 v155, v155
    s_nop 0
    v_add_f32 v30, v30, v148
    v_add_f32 v31, v31, v149
    v_cvt_pk_bf16_f32 v136, v148, v149
    v_add_f32 v30, v30, v150
    v_add_f32 v31, v31, v151
    v_cvt_pk_bf16_f32 v137, v150, v151
    v_add_f32 v30, v30, v152
    v_add_f32 v31, v31, v153
    v_cvt_pk_bf16_f32 v138, v152, v153
    v_add_f32 v30, v30, v154
    v_add_f32 v31, v31, v155
    v_cvt_pk_bf16_f32 v139, v154, v155
    s_waitcnt vmcnt(4)
    ds_read_b64_tr_b16 v[68:69], v22 offset:0
    ds_read_b64_tr_b16 v[72:73], v23 offset:0
    ds_read_b64_tr_b16 v[76:77], v24 offset:0
    ds_read_b64_tr_b16 v[80:81], v25 offset:0
    ds_read_b64_tr_b16 v[84:85], v26 offset:0
    ds_read_b64_tr_b16 v[88:89], v27 offset:0
    ds_read_b64_tr_b16 v[92:93], v28 offset:0
    ds_read_b64_tr_b16 v[96:97], v29 offset:0
    s_add_u32 m0, s23, 8192
    s_add_u32 s63, s62, 65536
    buffer_load_dwordx4 v16, s[28:31], s63 offen offset:0 nt lds
    buffer_load_dwordx4 v17, s[28:31], s63 offen offset:1024 nt lds
    buffer_load_dwordx4 v16, s[28:31], s63 offen offset:2048 nt lds
    buffer_load_dwordx4 v17, s[28:31], s63 offen offset:3072 nt lds
    buffer_load_dwordx4 v[32:35], off, s[44:47], s87
    s_waitcnt vmcnt(5) lgkmcnt(0)
    ds_read_b64_tr_b16 v[70:71], v22 offset:4096
    ds_read_b64_tr_b16 v[74:75], v23 offset:4096
    ds_read_b64_tr_b16 v[78:79], v24 offset:4096
    ds_read_b64_tr_b16 v[82:83], v25 offset:4096
    ds_read_b64_tr_b16 v[86:87], v26 offset:4096
    ds_read_b64_tr_b16 v[90:91], v27 offset:4096
    ds_read_b64_tr_b16 v[94:95], v28 offset:4096
    ds_read_b64_tr_b16 v[98:99], v29 offset:4096
    s_add_u32 m0, s23, 0
    s_add_u32 s63, s62, 81920
    buffer_load_dwordx4 v16, s[28:31], s63 offen offset:0 nt lds
    buffer_load_dwordx4 v17, s[28:31], s63 offen offset:1024 nt lds
    buffer_load_dwordx4 v16, s[28:31], s63 offen offset:2048 nt lds
    buffer_load_dwordx4 v17, s[28:31], s63 offen offset:3072 nt lds
    s_waitcnt lgkmcnt(7)
    v_mfma_f32_16x16x32_bf16 v[100:103], v[68:71], v[136:139], v[100:103]
    s_waitcnt lgkmcnt(6)
    v_mfma_f32_16x16x32_bf16 v[104:107], v[72:75], v[136:139], v[104:107]
    s_waitcnt lgkmcnt(5)
    v_mfma_f32_16x16x32_bf16 v[108:111], v[76:79], v[136:139], v[108:111]
    s_waitcnt lgkmcnt(4)
    v_mfma_f32_16x16x32_bf16 v[112:115], v[80:83], v[136:139], v[112:115]
    s_waitcnt lgkmcnt(3)
    v_mfma_f32_16x16x32_bf16 v[116:119], v[84:87], v[136:139], v[116:119]
    s_waitcnt lgkmcnt(2)
    v_mfma_f32_16x16x32_bf16 v[120:123], v[88:91], v[136:139], v[120:123]
    s_waitcnt lgkmcnt(1)
    v_mfma_f32_16x16x32_bf16 v[124:127], v[92:95], v[136:139], v[124:127]
    s_waitcnt lgkmcnt(0)
    v_mfma_f32_16x16x32_bf16 v[128:131], v[96:99], v[136:139], v[128:131]
    v_fma_f32 v156, v156, s66, -v37
    v_fma_f32 v157, v157, s66, -v37
    v_fma_f32 v158, v158, s66, -v37
    v_fma_f32 v159, v159, s66, -v37
    v_fma_f32 v160, v160, s66, -v37
    v_fma_f32 v161, v161, s66, -v37
    v_fma_f32 v162, v162, s66, -v37
    v_fma_f32 v163, v163, s66, -v37
    v_exp_f32 v156, v156
    v_exp_f32 v157, v157
    v_exp_f32 v158, v158
    v_exp_f32 v159, v159
    v_exp_f32 v160, v160
    v_exp_f32 v161, v161
    v_exp_f32 v162, v162
    v_exp_f32 v163, v163
    s_nop 0
    v_add_f32 v30, v30, v156
    v_add_f32 v31, v31, v157
    v_cvt_pk_bf16_f32 v132, v156, v157
    v_add_f32 v30, v30, v158
    v_add_f32 v31, v31, v159
    v_cvt_pk_bf16_f32 v133, v158, v159
    v_add_f32 v30, v30, v160
    v_add_f32 v31, v31, v161
    v_cvt_pk_bf16_f32 v134, v160, v161
    v_add_f32 v30, v30, v162
    v_add_f32 v31, v31, v163
    v_cvt_pk_bf16_f32 v135, v162, v163
    s_waitcnt vmcnt(5)
    ds_read_b64_tr_b16 v[68:69], v22 offset:8192
    ds_read_b64_tr_b16 v[72:73], v23 offset:8192
    ds_read_b64_tr_b16 v[76:77], v24 offset:8192
    ds_read_b64_tr_b16 v[80:81], v25 offset:8192
    ds_read_b64_tr_b16 v[84:85], v26 offset:8192
    ds_read_b64_tr_b16 v[88:89], v27 offset:8192
    ds_read_b64_tr_b16 v[92:93], v28 offset:8192
    ds_read_b64_tr_b16 v[96:97], v29 offset:8192
    s_add_u32 m0, s23, 4096
    s_add_u32 s63, s62, 98304
    buffer_load_dwordx4 v16, s[28:31], s63 offen offset:0 nt lds
    buffer_load_dwordx4 v17, s[28:31], s63 offen offset:1024 nt lds
    buffer_load_dwordx4 v16, s[28:31], s63 offen offset:2048 nt lds
    buffer_load_dwordx4 v17, s[28:31], s63 offen offset:3072 nt lds
    s_waitcnt vmcnt(4) lgkmcnt(0)
    ds_read_b64_tr_b16 v[70:71], v22 offset:0
    ds_read_b64_tr_b16 v[74:75], v23 offset:0
    ds_read_b64_tr_b16 v[78:79], v24 offset:0
    ds_read_b64_tr_b16 v[82:83], v25 offset:0
    ds_read_b64_tr_b16 v[86:87], v26 offset:0
    ds_read_b64_tr_b16 v[90:91], v27 offset:0
    ds_read_b64_tr_b16 v[94:95], v28 offset:0
    ds_read_b64_tr_b16 v[98:99], v29 offset:0
    s_add_u32 m0, s23, 8192
    s_add_u32 s63, s62, 114688
    buffer_load_dwordx4 v16, s[28:31], s63 offen offset:0 nt lds
    buffer_load_dwordx4 v17, s[28:31], s63 offen offset:1024 nt lds
    buffer_load_dwordx4 v16, s[28:31], s63 offen offset:2048 nt lds
    buffer_load_dwordx4 v17, s[28:31], s63 offen offset:3072 nt lds
    s_waitcnt lgkmcnt(7)
    v_mfma_f32_16x16x32_bf16 v[100:103], v[68:71], v[132:135], v[100:103]
    s_waitcnt lgkmcnt(6)
    v_mfma_f32_16x16x32_bf16 v[104:107], v[72:75], v[132:135], v[104:107]
    s_waitcnt lgkmcnt(5)
    v_mfma_f32_16x16x32_bf16 v[108:111], v[76:79], v[132:135], v[108:111]
    s_waitcnt lgkmcnt(4)
    v_mfma_f32_16x16x32_bf16 v[112:115], v[80:83], v[132:135], v[112:115]
    s_waitcnt lgkmcnt(3)
    v_mfma_f32_16x16x32_bf16 v[116:119], v[84:87], v[132:135], v[116:119]
    s_waitcnt lgkmcnt(2)
    v_mfma_f32_16x16x32_bf16 v[120:123], v[88:91], v[132:135], v[120:123]
    s_waitcnt lgkmcnt(1)
    v_mfma_f32_16x16x32_bf16 v[124:127], v[92:95], v[132:135], v[124:127]
    s_waitcnt lgkmcnt(0)
    v_mfma_f32_16x16x32_bf16 v[128:131], v[96:99], v[132:135], v[128:131]
    v_fma_f32 v164, v164, s66, -v37
    v_fma_f32 v165, v165, s66, -v37
    v_fma_f32 v166, v166, s66, -v37
    v_fma_f32 v167, v167, s66, -v37
    v_fma_f32 v168, v168, s66, -v37
    v_fma_f32 v169, v169, s66, -v37
    v_fma_f32 v170, v170, s66, -v37
    v_fma_f32 v171, v171, s66, -v37
    v_exp_f32 v164, v164
    v_exp_f32 v165, v165
    v_exp_f32 v166, v166
    v_exp_f32 v167, v167
    v_exp_f32 v168, v168
    v_exp_f32 v169, v169
    v_exp_f32 v170, v170
    v_exp_f32 v171, v171
    s_nop 0
    v_add_f32 v30, v30, v164
    v_add_f32 v31, v31, v165
    v_cvt_pk_bf16_f32 v136, v164, v165
    v_add_f32 v30, v30, v166
    v_add_f32 v31, v31, v167
    v_cvt_pk_bf16_f32 v137, v166, v167
    v_add_f32 v30, v30, v168
    v_add_f32 v31, v31, v169
    v_cvt_pk_bf16_f32 v138, v168, v169
    v_add_f32 v30, v30, v170
    v_add_f32 v31, v31, v171
    v_cvt_pk_bf16_f32 v139, v170, v171
    s_cmp_lg_u32 s22, 0
    s_cbranch_scc1 L_notree1
    v_lshlrev_b32 v4, 4, v2
    v_add_u32 v4, 49664, v4
    ds_read_b128 v[140:143], v4 offset:0
    ds_read_b128 v[144:147], v4 offset:64
    ds_read_b128 v[148:151], v4 offset:128
    ds_read_b128 v[152:155], v4 offset:192
    s_waitcnt lgkmcnt(0)
    v_mfma_f32_16x16x32_bf16 v[156:159], v[140:143], v[52:55], 0
    v_mfma_f32_16x16x32_bf16 v[156:159], v[144:147], v[56:59], v[156:159]
    v_mfma_f32_16x16x32_bf16 v[156:159], v[148:151], v[60:63], v[156:159]
    v_mfma_f32_16x16x32_bf16 v[156:159], v[152:155], v[64:67], v[156:159]
    s_lshr_b32 s67, s60, 2
    s_lshl_b32 s67, s67, 4
    s_lshr_b32 s65, s65, s67
    s_lshl_b32 s65, s65, 16
    s_lshr_b32 s70, s61, 2
    v_mov_b32 v4, s65
    v_sub_f32 v4, 1.0, v4
    v_mul_f32 v4, 3467377551, v4
    v_lshlrev_b32 v50, 16, v50
    s_nop 1
    v_fma_f32 v4, v156, s66, v4
    s_nop 0
    v_readlane_b32 s64, v4, s70
L_notree1:
    s_waitcnt vmcnt(4)
    ds_read_b64_tr_b16 v[68:69], v22 offset:4096
    ds_read_b64_tr_b16 v[72:73], v23 offset:4096
    ds_read_b64_tr_b16 v[76:77], v24 offset:4096
    ds_read_b64_tr_b16 v[80:81], v25 offset:4096
    ds_read_b64_tr_b16 v[84:85], v26 offset:4096
    ds_read_b64_tr_b16 v[88:89], v27 offset:4096
    ds_read_b64_tr_b16 v[92:93], v28 offset:4096
    ds_read_b64_tr_b16 v[96:97], v29 offset:4096
    s_add_u32 m0, s23, 0
    s_add_u32 s63, s62, 131072
    buffer_load_dwordx4 v16, s[28:31], s63 offen offset:0 nt lds
    buffer_load_dwordx4 v17, s[28:31], s63 offen offset:1024 nt lds
    buffer_load_dwordx4 v16, s[28:31], s63 offen offset:2048 nt lds
    buffer_load_dwordx4 v17, s[28:31], s63 offen offset:3072 nt lds
    s_waitcnt vmcnt(4) lgkmcnt(0)
    ds_read_b64_tr_b16 v[70:71], v22 offset:8192
    ds_read_b64_tr_b16 v[74:75], v23 offset:8192
    ds_read_b64_tr_b16 v[78:79], v24 offset:8192
    ds_read_b64_tr_b16 v[82:83], v25 offset:8192
    ds_read_b64_tr_b16 v[86:87], v26 offset:8192
    ds_read_b64_tr_b16 v[90:91], v27 offset:8192
    ds_read_b64_tr_b16 v[94:95], v28 offset:8192
    ds_read_b64_tr_b16 v[98:99], v29 offset:8192
    s_add_u32 m0, s23, 4096
    s_add_u32 s63, s62, 147456
    buffer_load_dwordx4 v16, s[28:31], s63 offen offset:0 nt lds
    buffer_load_dwordx4 v17, s[28:31], s63 offen offset:1024 nt lds
    buffer_load_dwordx4 v16, s[28:31], s63 offen offset:2048 nt lds
    buffer_load_dwordx4 v17, s[28:31], s63 offen offset:3072 nt lds
    s_waitcnt lgkmcnt(7)
    v_mfma_f32_16x16x32_bf16 v[100:103], v[68:71], v[136:139], v[100:103]
    s_waitcnt lgkmcnt(6)
    v_mfma_f32_16x16x32_bf16 v[104:107], v[72:75], v[136:139], v[104:107]
    s_waitcnt lgkmcnt(5)
    v_mfma_f32_16x16x32_bf16 v[108:111], v[76:79], v[136:139], v[108:111]
    s_waitcnt lgkmcnt(4)
    v_mfma_f32_16x16x32_bf16 v[112:115], v[80:83], v[136:139], v[112:115]
    s_waitcnt lgkmcnt(3)
    v_mfma_f32_16x16x32_bf16 v[116:119], v[84:87], v[136:139], v[116:119]
    s_waitcnt lgkmcnt(2)
    v_mfma_f32_16x16x32_bf16 v[120:123], v[88:91], v[136:139], v[120:123]
    s_waitcnt lgkmcnt(1)
    v_mfma_f32_16x16x32_bf16 v[124:127], v[92:95], v[136:139], v[124:127]
    s_waitcnt lgkmcnt(0)
    v_mfma_f32_16x16x32_bf16 v[128:131], v[96:99], v[136:139], v[128:131]
    v_fma_f32 v172, v172, s66, -v37
    v_fma_f32 v173, v173, s66, -v37
    v_fma_f32 v174, v174, s66, -v37
    v_fma_f32 v175, v175, s66, -v37
    v_fma_f32 v176, v176, s66, -v37
    v_fma_f32 v177, v177, s66, -v37
    v_fma_f32 v178, v178, s66, -v37
    v_fma_f32 v179, v179, s66, -v37
    v_exp_f32 v172, v172
    v_exp_f32 v173, v173
    v_exp_f32 v174, v174
    v_exp_f32 v175, v175
    v_exp_f32 v176, v176
    v_exp_f32 v177, v177
    v_exp_f32 v178, v178
    v_exp_f32 v179, v179
    s_nop 0
    v_add_f32 v30, v30, v172
    v_add_f32 v31, v31, v173
    v_cvt_pk_bf16_f32 v132, v172, v173
    v_add_f32 v30, v30, v174
    v_add_f32 v31, v31, v175
    v_cvt_pk_bf16_f32 v133, v174, v175
    v_add_f32 v30, v30, v176
    v_add_f32 v31, v31, v177
    v_cvt_pk_bf16_f32 v134, v176, v177
    v_add_f32 v30, v30, v178
    v_add_f32 v31, v31, v179
    v_cvt_pk_bf16_f32 v135, v178, v179
    s_waitcnt vmcnt(4)
    ds_read_b64_tr_b16 v[68:69], v22 offset:0
    ds_read_b64_tr_b16 v[72:73], v23 offset:0
    ds_read_b64_tr_b16 v[76:77], v24 offset:0
    ds_read_b64_tr_b16 v[80:81], v25 offset:0
    ds_read_b64_tr_b16 v[84:85], v26 offset:0
    ds_read_b64_tr_b16 v[88:89], v27 offset:0
    ds_read_b64_tr_b16 v[92:93], v28 offset:0
    ds_read_b64_tr_b16 v[96:97], v29 offset:0
    s_add_u32 m0, s23, 8192
    s_add_u32 s63, s62, 163840
    buffer_load_dwordx4 v16, s[28:31], s63 offen offset:0 nt lds
    buffer_load_dwordx4 v17, s[28:31], s63 offen offset:1024 nt lds
    buffer_load_dwordx4 v16, s[28:31], s63 offen offset:2048 nt lds
    buffer_load_dwordx4 v17, s[28:31], s63 offen offset:3072 nt lds
    v_and_b32 v9, 7, v1
    v_lshlrev_b32 v9, 7, v9
    s_lshl_b32 s67, s22, 10
    s_add_u32 s67, s67, s56
    buffer_load_dword v9, v9, s[36:39], s67 offen sc1
    s_waitcnt vmcnt(5) lgkmcnt(0)
    ds_read_b64_tr_b16 v[70:71], v22 offset:4096
    ds_read_b64_tr_b16 v[74:75], v23 offset:4096
    ds_read_b64_tr_b16 v[78:79], v24 offset:4096
    ds_read_b64_tr_b16 v[82:83], v25 offset:4096
    ds_read_b64_tr_b16 v[86:87], v26 offset:4096
    ds_read_b64_tr_b16 v[90:91], v27 offset:4096
    ds_read_b64_tr_b16 v[94:95], v28 offset:4096
    ds_read_b64_tr_b16 v[98:99], v29 offset:4096
    s_add_u32 m0, s23, 0
    s_add_u32 s63, s62, 180224
    buffer_load_dwordx4 v16, s[28:31], s63 offen offset:0 nt lds
    buffer_load_dwordx4 v17, s[28:31], s63 offen offset:1024 nt lds
    buffer_load_dwordx4 v16, s[28:31], s63 offen offset:2048 nt lds
    buffer_load_dwordx4 v17, s[28:31], s63 offen offset:3072 nt lds
    s_waitcnt lgkmcnt(7)
    v_mfma_f32_16x16x32_bf16 v[100:103], v[68:71], v[132:135], v[100:103]
    s_waitcnt lgkmcnt(6)
    v_mfma_f32_16x16x32_bf16 v[104:107], v[72:75], v[132:135], v[104:107]
    s_waitcnt lgkmcnt(5)
    v_mfma_f32_16x16x32_bf16 v[108:111], v[76:79], v[132:135], v[108:111]
    s_waitcnt lgkmcnt(4)
    v_mfma_f32_16x16x32_bf16 v[112:115], v[80:83], v[132:135], v[112:115]
    s_waitcnt lgkmcnt(3)
    v_mfma_f32_16x16x32_bf16 v[116:119], v[84:87], v[132:135], v[116:119]
    s_waitcnt lgkmcnt(2)
    v_mfma_f32_16x16x32_bf16 v[120:123], v[88:91], v[132:135], v[120:123]
    s_waitcnt lgkmcnt(1)
    v_mfma_f32_16x16x32_bf16 v[124:127], v[92:95], v[132:135], v[124:127]
    s_waitcnt lgkmcnt(0)
    v_mfma_f32_16x16x32_bf16 v[128:131], v[96:99], v[132:135], v[128:131]
    v_fma_f32 v180, v180, s66, -v37
    v_fma_f32 v181, v181, s66, -v37
    v_fma_f32 v182, v182, s66, -v37
    v_fma_f32 v183, v183, s66, -v37
    v_fma_f32 v184, v184, s66, -v37
    v_fma_f32 v185, v185, s66, -v37
    v_fma_f32 v186, v186, s66, -v37
    v_fma_f32 v187, v187, s66, -v37
    v_exp_f32 v180, v180
    v_exp_f32 v181, v181
    v_exp_f32 v182, v182
    v_exp_f32 v183, v183
    v_exp_f32 v184, v184
    v_exp_f32 v185, v185
    v_exp_f32 v186, v186
    v_exp_f32 v187, v187
    s_nop 0
    v_add_f32 v30, v30, v180
    v_add_f32 v31, v31, v181
    v_cvt_pk_bf16_f32 v136, v180, v181
    v_add_f32 v30, v30, v182
    v_add_f32 v31, v31, v183
    v_cvt_pk_bf16_f32 v137, v182, v183
    v_add_f32 v30, v30, v184
    v_add_f32 v31, v31, v185
    v_cvt_pk_bf16_f32 v138, v184, v185
    v_add_f32 v30, v30, v186
    v_add_f32 v31, v31, v187
    v_cvt_pk_bf16_f32 v139, v186, v187
    s_waitcnt vmcnt(5)
    ds_read_b64_tr_b16 v[68:69], v22 offset:8192
    ds_read_b64_tr_b16 v[72:73], v23 offset:8192
    ds_read_b64_tr_b16 v[76:77], v24 offset:8192
    ds_read_b64_tr_b16 v[80:81], v25 offset:8192
    ds_read_b64_tr_b16 v[84:85], v26 offset:8192
    ds_read_b64_tr_b16 v[88:89], v27 offset:8192
    ds_read_b64_tr_b16 v[92:93], v28 offset:8192
    ds_read_b64_tr_b16 v[96:97], v29 offset:8192
    s_add_u32 m0, s23, 4096
    s_add_u32 s63, s62, 196608
    buffer_load_dwordx4 v16, s[28:31], s63 offen offset:0 nt lds
    buffer_load_dwordx4 v17, s[28:31], s63 offen offset:1024 nt lds
    buffer_load_dwordx4 v16, s[28:31], s63 offen offset:2048 nt lds
    buffer_load_dwordx4 v17, s[28:31], s63 offen offset:3072 nt lds
    s_waitcnt vmcnt(4) lgkmcnt(0)
    ds_read_b64_tr_b16 v[70:71], v22 offset:0
    ds_read_b64_tr_b16 v[74:75], v23 offset:0
    ds_read_b64_tr_b16 v[78:79], v24 offset:0
    ds_read_b64_tr_b16 v[82:83], v25 offset:0
    ds_read_b64_tr_b16 v[86:87], v26 offset:0
    ds_read_b64_tr_b16 v[90:91], v27 offset:0
    ds_read_b64_tr_b16 v[94:95], v28 offset:0
    ds_read_b64_tr_b16 v[98:99], v29 offset:0
    s_add_u32 m0, s23, 8192
    s_add_u32 s63, s62, 212992
    buffer_load_dwordx4 v16, s[28:31], s63 offen offset:0 nt lds
    buffer_load_dwordx4 v17, s[28:31], s63 offen offset:1024 nt lds
    buffer_load_dwordx4 v16, s[28:31], s63 offen offset:2048 nt lds
    buffer_load_dwordx4 v17, s[28:31], s63 offen offset:3072 nt lds
    s_waitcnt lgkmcnt(7)
    v_mfma_f32_16x16x32_bf16 v[100:103], v[68:71], v[136:139], v[100:103]
    s_waitcnt lgkmcnt(6)
    v_mfma_f32_16x16x32_bf16 v[104:107], v[72:75], v[136:139], v[104:107]
    s_waitcnt lgkmcnt(5)
    v_mfma_f32_16x16x32_bf16 v[108:111], v[76:79], v[136:139], v[108:111]
    s_waitcnt lgkmcnt(4)
    v_mfma_f32_16x16x32_bf16 v[112:115], v[80:83], v[136:139], v[112:115]
    s_waitcnt lgkmcnt(3)
    v_mfma_f32_16x16x32_bf16 v[116:119], v[84:87], v[136:139], v[116:119]
    s_waitcnt lgkmcnt(2)
    v_mfma_f32_16x16x32_bf16 v[120:123], v[88:91], v[136:139], v[120:123]
    s_waitcnt lgkmcnt(1)
    v_mfma_f32_16x16x32_bf16 v[124:127], v[92:95], v[136:139], v[124:127]
    s_waitcnt lgkmcnt(0)
    v_mfma_f32_16x16x32_bf16 v[128:131], v[96:99], v[136:139], v[128:131]
    v_fma_f32 v188, v188, s66, -v37
    v_fma_f32 v189, v189, s66, -v37
    v_fma_f32 v190, v190, s66, -v37
    v_fma_f32 v191, v191, s66, -v37
    v_fma_f32 v192, v192, s66, -v37
    v_fma_f32 v193, v193, s66, -v37
    v_fma_f32 v194, v194, s66, -v37
    v_fma_f32 v195, v195, s66, -v37
    v_exp_f32 v188, v188
    v_exp_f32 v189, v189
    v_exp_f32 v190, v190
    v_exp_f32 v191, v191
    v_exp_f32 v192, v192
    v_exp_f32 v193, v193
    v_exp_f32 v194, v194
    v_exp_f32 v195, v195
    s_nop 0
    v_add_f32 v30, v30, v188
    v_add_f32 v31, v31, v189
    v_add_f32 v30, v30, v190
    v_add_f32 v31, v31, v191
    v_add_f32 v30, v30, v192
    v_add_f32 v31, v31, v193
    v_add_f32 v30, v30, v194
    v_add_f32 v31, v31, v195
    v_fma_f32 v196, v196, s66, -v37
    v_fma_f32 v197, v197, s66, -v37
    v_fma_f32 v198, v198, s66, -v37
    v_fma_f32 v199, v199, s66, -v37
    v_fma_f32 v200, v200, s66, -v37
    v_fma_f32 v201, v201, s66, -v37
    v_fma_f32 v202, v202, s66, -v37
    v_fma_f32 v203, v203, s66, -v37
    v_exp_f32 v196, v196
    v_exp_f32 v197, v197
    v_exp_f32 v198, v198
    v_exp_f32 v199, v199
    v_exp_f32 v200, v200
    v_exp_f32 v201, v201
    v_exp_f32 v202, v202
    v_exp_f32 v203, v203
    s_nop 0
    v_add_f32 v30, v30, v196
    v_add_f32 v31, v31, v197
    v_add_f32 v30, v30, v198
    v_add_f32 v31, v31, v199
    v_add_f32 v30, v30, v200
    v_add_f32 v31, v31, v201
    v_add_f32 v30, v30, v202
    v_add_f32 v31, v31, v203
    s_waitcnt vmcnt(4)
    ds_read_b64_tr_b16 v[68:69], v22 offset:4096
    ds_read_b64_tr_b16 v[72:73], v23 offset:4096
    ds_read_b64_tr_b16 v[76:77], v24 offset:4096
    ds_read_b64_tr_b16 v[80:81], v25 offset:4096
    ds_read_b64_tr_b16 v[84:85], v26 offset:4096
    ds_read_b64_tr_b16 v[88:89], v27 offset:4096
    ds_read_b64_tr_b16 v[92:93], v28 offset:4096
    ds_read_b64_tr_b16 v[96:97], v29 offset:4096
    s_add_u32 m0, s23, 0
    s_add_u32 s63, s62, 229376
    buffer_load_dwordx4 v16, s[28:31], s63 offen offset:0 nt lds
    buffer_load_dwordx4 v17, s[28:31], s63 offen offset:1024 nt lds
    buffer_load_dwordx4 v16, s[28:31], s63 offen offset:2048 nt lds
    buffer_load_dwordx4 v17, s[28:31], s63 offen offset:3072 nt lds
    s_waitcnt lgkmcnt(0)
    s_add_u32 m0, s23, 4096
    s_add_u32 s63, s62, 245760
    buffer_load_dwordx4 v16, s[28:31], s63 offen offset:0 nt lds
    buffer_load_dwordx4 v17, s[28:31], s63 offen offset:1024 nt lds
    buffer_load_dwordx4 v16, s[28:31], s63 offen offset:2048 nt lds
    buffer_load_dwordx4 v17, s[28:31], s63 offen offset:3072 nt lds
    v_add_f32 v30, v30, v31
    v_mov_b32 v4, v30
    s_nop 1
    v_permlane16_swap_b32 v30, v4
    v_add_f32 v30, v30, v4
    v_mov_b32 v4, v30
    s_nop 1
    v_permlane32_swap_b32 v30, v4
    v_add_f32 v30, v30, v4
    ds_write_b32 v45, v30 offset:256
    v_cmp_eq_u32 vcc, 0, v34
    s_cbranch_vccnz L_non
L_nonok:
    v_readfirstlane_b32 s54, v32
    v_readfirstlane_b32 s55, v33
    v_readfirstlane_b32 s89, v34
    v_mov_b32 v151, v32
    v_mov_b32 v154, v32
    v_mov_b32 v155, v33
    s_mov_b32 s50, 0x07060501
    s_mov_b32 s51, 0x07060502
    s_mov_b32 s52, 0x07060503
    s_mov_b32 s48, 0x0c04000c
    s_mov_b32 s49, 0x04020100
    s_cmp_eq_u32 s89, s86
    s_cselect_b32 s88, 0, 0x80000000
    s_mov_b32 s59, 0
    s_lshl_b32 s67, s22, 1
    s_lshl_b32 s94, 0x00030003, s67
    s_mov_b32 s95, s94
    s_waitcnt lgkmcnt(0)
    s_barrier
    ds_read_b128 v[140:143], v44
    ds_read_b128 v[144:147], v44 offset:256
    s_waitcnt lgkmcnt(1)
    v_max3_f32 v152, v140, v141, v142
    v_max_f32 v152, v152, v143
    v_sub_f32 v4, v37, v152
    v_sub_f32 v140, v140, v152
    v_sub_f32 v141, v141, v152
    v_sub_f32 v142, v142, v152
    v_sub_f32 v143, v143, v152
    v_exp_f32 v4, v4
    v_exp_f32 v140, v140
    v_exp_f32 v141, v141
    v_exp_f32 v142, v142
    v_exp_f32 v143, v143
    s_waitcnt lgkmcnt(0)
    v_mul_f32 v153, v140, v144
    v_fmac_f32 v153, v141, v145
    v_fmac_f32 v153, v142, v146
    v_fmac_f32 v153, v143, v147
    v_and_b32 v153, 0x7fffffff, v153
    v_or_b32 v153, s88, v153
    s_mov_b64 exec, s[94:95]
    s_cmp_lg_u32 s88, 0
    s_cbranch_scc1 L_far1
    buffer_store_dwordx4 v[152:155], v38, s[36:39], s69 offen
L_back1:
    s_mov_b64 exec, -1
    v_mul_f32 v188, v4, v188
    v_mul_f32 v189, v4, v189
    v_mul_f32 v190, v4, v190
    v_mul_f32 v191, v4, v191
    v_mul_f32 v192, v4, v192
    v_mul_f32 v193, v4, v193
    v_mul_f32 v194, v4, v194
    v_mul_f32 v195, v4, v195
    v_mul_f32 v196, v4, v196
    v_mul_f32 v197, v4, v197
    v_mul_f32 v198, v4, v198
    v_mul_f32 v199, v4, v199
    v_mul_f32 v200, v4, v200
    v_mul_f32 v201, v4, v201
    v_mul_f32 v202, v4, v202
    v_mul_f32 v203, v4, v203
    v_cvt_pk_bf16_f32 v132, v188, v189
    v_cvt_pk_bf16_f32 v133, v190, v191
    v_cvt_pk_bf16_f32 v134, v192, v193
    v_cvt_pk_bf16_f32 v135, v194, v195
    v_cvt_pk_bf16_f32 v136, v196, v197
    v_cvt_pk_bf16_f32 v137, v198, v199
    v_cvt_pk_bf16_f32 v138, v200, v201
    v_cvt_pk_bf16_f32 v139, v202, v203
    s_lshl_b32 s67, s22, 10
    v_add_u32 v5, s67, v41
    ds_write_b128 v5, v[136:139]
    v_mul_f32 v100, v4, v100
    v_mul_f32 v101, v4, v101
    v_mul_f32 v102, v4, v102
    v_mul_f32 v103, v4, v103
    v_mul_f32 v104, v4, v104
    v_mul_f32 v105, v4, v105
    v_mul_f32 v106, v4, v106
    v_mul_f32 v107, v4, v107
    v_mul_f32 v108, v4, v108
    v_mul_f32 v109, v4, v109
    v_mul_f32 v110, v4, v110
    v_mul_f32 v111, v4, v111
    v_mul_f32 v112, v4, v112
    v_mul_f32 v113, v4, v113
    v_mul_f32 v114, v4, v114
    v_mul_f32 v115, v4, v115
    v_mul_f32 v116, v4, v116
    v_mul_f32 v117, v4, v117
    v_mul_f32 v118, v4, v118
    v_mul_f32 v119, v4, v119
    v_mul_f32 v120, v4, v120
    v_mul_f32 v121, v4, v121
    v_mul_f32 v122, v4, v122
    v_mul_f32 v123, v4, v123
    v_mul_f32 v124, v4, v124
    v_mul_f32 v125, v4, v125
    v_mul_f32 v126, v4, v126
    v_mul_f32 v127, v4, v127
    v_mul_f32 v128, v4, v128
    v_mul_f32 v129, v4, v129
    v_mul_f32 v130, v4, v130
    v_mul_f32 v131, v4, v131
    s_mov_b32 s94, 0xff00ff00
    s_mov_b32 s95, 0xff00ff00
    s_waitcnt vmcnt(9) lgkmcnt(0)
    ds_read_b64_tr_b16 v[70:71], v22 offset:8192
    ds_read_b64_tr_b16 v[74:75], v23 offset:8192
    ds_read_b64_tr_b16 v[78:79], v24 offset:8192
    ds_read_b64_tr_b16 v[82:83], v25 offset:8192
    ds_read_b64_tr_b16 v[86:87], v26 offset:8192
    ds_read_b64_tr_b16 v[90:91], v27 offset:8192
    ds_read_b64_tr_b16 v[94:95], v28 offset:8192
    ds_read_b64_tr_b16 v[98:99], v29 offset:8192
    s_waitcnt lgkmcnt(7)
    v_mfma_f32_16x16x32_bf16 v[100:103], v[68:71], v[132:135], v[100:103]
    s_waitcnt lgkmcnt(6)
    v_mfma_f32_16x16x32_bf16 v[104:107], v[72:75], v[132:135], v[104:107]
    s_waitcnt lgkmcnt(5)
    v_mfma_f32_16x16x32_bf16 v[108:111], v[76:79], v[132:135], v[108:111]
    s_nop 3
    ds_write_b128 v39, v[100:103] offset:0
    s_waitcnt lgkmcnt(5)
    v_mfma_f32_16x16x32_bf16 v[112:115], v[80:83], v[132:135], v[112:115]
    s_nop 1
    ds_write_b128 v39, v[104:107] offset:64
    s_waitcnt lgkmcnt(5)
    v_mfma_f32_16x16x32_bf16 v[116:119], v[84:87], v[132:135], v[116:119]
    s_nop 1
    ds_write_b128 v39, v[108:111] offset:128
    s_waitcnt lgkmcnt(5)
    v_mfma_f32_16x16x32_bf16 v[120:123], v[88:91], v[132:135], v[120:123]
    s_nop 1
    ds_write_b128 v39, v[112:115] offset:192
    s_waitcnt lgkmcnt(5)
    v_mfma_f32_16x16x32_bf16 v[124:127], v[92:95], v[132:135], v[124:127]
    s_nop 1
    ds_write_b128 v39, v[116:119] offset:256
    s_waitcnt lgkmcnt(5)
    v_mfma_f32_16x16x32_bf16 v[128:131], v[96:99], v[132:135], v[128:131]
    s_nop 1
    ds_write_b128 v39, v[120:123] offset:320
    s_nop 2
    ds_write_b128 v39, v[124:127] offset:384
    s_nop 2
    ds_write_b128 v39, v[128:131] offset:448
    s_waitcnt lgkmcnt(0)
    s_barrier
    ds_read_b128 v[68:71], v40 offset:0
    ds_read_b128 v[72:75], v40 offset:4224
    ds_read_b128 v[76:79], v40 offset:8448
    ds_read_b128 v[80:83], v40 offset:12672
    ds_read_b128 v[84:87], v40 offset:64
    ds_read_b128 v[88:91], v40 offset:4288
    ds_read_b128 v[92:95], v40 offset:8512
    ds_read_b128 v[96:99], v40 offset:12736
    ds_read_b128 v[160:163], v41 offset:0
    ds_read_b128 v[164:167], v41 offset:1024
    ds_read_b128 v[168:171], v41 offset:2048
    ds_read_b128 v[172:175], v41 offset:3072
    s_waitcnt lgkmcnt(8)
    v_add_f32 v68, v68, v72
    v_add_f32 v76, v76, v80
    v_add_f32 v69, v69, v73
    v_add_f32 v77, v77, v81
    v_add_f32 v70, v70, v74
    v_add_f32 v78, v78, v82
    v_add_f32 v71, v71, v75
    v_add_f32 v79, v79, v83
    v_add_f32 v176, v68, v76
    v_add_f32 v177, v69, v77
    v_add_f32 v178, v70, v78
    v_add_f32 v179, v71, v79
    s_waitcnt lgkmcnt(4)
    v_add_f32 v84, v84, v88
    v_add_f32 v92, v92, v96
    v_add_f32 v85, v85, v89
    v_add_f32 v93, v93, v97
    v_add_f32 v86, v86, v90
    v_add_f32 v94, v94, v98
    v_add_f32 v87, v87, v91
    v_add_f32 v95, v95, v99
    v_add_f32 v180, v84, v92
    v_add_f32 v181, v85, v93
    v_add_f32 v182, v86, v94
    v_add_f32 v183, v87, v95
    s_waitcnt vmcnt(1) lgkmcnt(0)
    s_barrier
    ds_read_b64_tr_b16 v[68:69], v42 offset:0
    ds_read_b64_tr_b16 v[70:71], v42 offset:4096
    ds_read_b64_tr_b16 v[72:73], v43 offset:0
    ds_read_b64_tr_b16 v[74:75], v43 offset:4096
    ds_read_b64_tr_b16 v[76:77], v42 offset:12288
    ds_read_b64_tr_b16 v[78:79], v42 offset:16384
    ds_read_b64_tr_b16 v[80:81], v43 offset:12288
    ds_read_b64_tr_b16 v[82:83], v43 offset:16384
    ds_read_b64_tr_b16 v[84:85], v42 offset:24576
    ds_read_b64_tr_b16 v[86:87], v42 offset:28672
    ds_read_b64_tr_b16 v[88:89], v43 offset:24576
    ds_read_b64_tr_b16 v[90:91], v43 offset:28672
    ds_read_b64_tr_b16 v[92:93], v42 offset:36864
    ds_read_b64_tr_b16 v[94:95], v42 offset:40960
    ds_read_b64_tr_b16 v[96:97], v43 offset:36864
    ds_read_b64_tr_b16 v[98:99], v43 offset:40960
    s_cmp_lg_u32 s22, 0
    s_cbranch_scc1 L_noml
    buffer_load_dwordx4 v[156:159], v48, s[36:39], s57 offen sc1
L_noml:
    s_waitcnt lgkmcnt(14)
    v_mfma_f32_16x16x32_bf16 v[176:179], v[68:71], v[160:163], v[176:179]
    s_waitcnt lgkmcnt(12)
    v_mfma_f32_16x16x32_bf16 v[180:183], v[72:75], v[160:163], v[180:183]
    s_waitcnt lgkmcnt(10)
    v_mfma_f32_16x16x32_bf16 v[176:179], v[76:79], v[164:167], v[176:179]
    s_waitcnt lgkmcnt(8)
    v_mfma_f32_16x16x32_bf16 v[180:183], v[80:83], v[164:167], v[180:183]
    s_waitcnt lgkmcnt(6)
    v_mfma_f32_16x16x32_bf16 v[176:179], v[84:87], v[168:171], v[176:179]
    s_waitcnt lgkmcnt(4)
    v_mfma_f32_16x16x32_bf16 v[180:183], v[88:91], v[168:171], v[180:183]
    s_waitcnt lgkmcnt(2)
    v_mfma_f32_16x16x32_bf16 v[176:179], v[92:95], v[172:175], v[176:179]
    s_waitcnt lgkmcnt(0)
    v_mfma_f32_16x16x32_bf16 v[180:183], v[96:99], v[172:175], v[180:183]
    s_nop 7
    v_cndmask_b32 v176, v176, v180, s[94:95]
    v_cndmask_b32 v177, v177, v181, s[94:95]
    v_cndmask_b32 v178, v178, v182, s[94:95]
    v_cndmask_b32 v179, v179, v183, s[94:95]
    v_perm_b32 v148, v176, v179, s50
    v_perm_b32 v149, v177, v179, s51
    v_perm_b32 v150, v178, v179, s52
    s_cmp_lg_u32 s88, 0
    s_cbranch_scc1 L_far2
    buffer_store_dwordx4 v[148:151], v36, s[36:39], s68 offen
L_back2:
    s_cmp_lg_u32 s22, 0
    s_cbranch_scc1 L_side
    buffer_load_dwordx4 v[100:103], v47, s[36:39], s56 offen offset:0 sc1
    buffer_load_dwordx4 v[104:107], v47, s[36:39], s56 offen offset:1024 sc1
    buffer_load_dwordx4 v[108:111], v47, s[36:39], s56 offen offset:2048 sc1
    buffer_load_dwordx4 v[112:115], v47, s[36:39], s56 offen offset:3072 sc1
    s_waitcnt vmcnt(5)
    v_cmp_ne_u64 vcc, s[54:55], v[158:159]
    s_cbranch_vccnz L_mlpoll
L_mlok:
    v_max_f32 v116, s64, v156
    s_nop 1
    v_max_f32_dpp v116, v116, v116 quad_perm:[1,0,3,2] row_mask:0xf bank_mask:0xf
    s_nop 1
    v_max_f32_dpp v116, v116, v116 quad_perm:[2,3,0,1] row_mask:0xf bank_mask:0xf
    s_nop 1
    v_max_f32_dpp v116, v116, v116 row_ror:8 row_mask:0xf bank_mask:0xf
    v_mov_b32 v117, v116
    s_nop 1
    v_permlane16_swap_b32 v116, v117
    v_max_f32 v116, v116, v117
    v_mov_b32 v117, v116
    s_nop 1
    v_permlane32_swap_b32 v116, v117
    v_max_f32 v116, v116, v117
    v_sub_f32 v118, v156, v116
    v_sub_f32 v119, s64, v116
    v_exp_f32 v118, v118
    v_exp_f32 v119, v119
    buffer_load_dwordx4 v[84:87], v47, s[36:39], s56 offen offset:0 sc1
    buffer_load_dwordx4 v[88:91], v47, s[36:39], s56 offen offset:1024 sc1
    buffer_load_dwordx4 v[92:95], v47, s[36:39], s56 offen offset:2048 sc1
    buffer_load_dwordx4 v[96:99], v47, s[36:39], s56 offen offset:3072 sc1
    v_cmp_gt_i32 s[90:91], 0, v157
    v_mul_f32 v120, v118, abs(v157)
    s_nop 1
    v_add_f32_dpp v120, v120, v120 quad_perm:[1,0,3,2] row_mask:0xf bank_mask:0xf
    s_nop 1
    v_add_f32_dpp v120, v120, v120 quad_perm:[2,3,0,1] row_mask:0xf bank_mask:0xf
    s_nop 1
    v_add_f32_dpp v120, v120, v120 row_ror:8 row_mask:0xf bank_mask:0xf
    v_mov_b32 v117, v120
    s_nop 1
    v_permlane16_swap_b32 v120, v117
    v_add_f32 v120, v120, v117
    v_mov_b32 v117, v120
    s_nop 1
    v_permlane32_swap_b32 v120, v117
    v_add_f32 v120, v120, v117
    v_add_f32 v120, v120, v119
    v_rcp_f32 v120, v120
    s_nop 0
    v_mul_f32 v118, v118, v120
    v_mul_f32 v119, v119, v120
    v_mul_f32 v50, v119, v50
    s_mov_b32 s92, 0x00ff00ff
    s_mov_b32 s93, 0x00ff00ff
L_pa:
    s_waitcnt vmcnt(4)
    v_cmp_ne_u32 s[24:25], s54, v103
    v_cmp_ne_u32 s[26:27], s54, v107
    v_cmp_ne_u32 s[28:29], s54, v111
    v_cmp_ne_u32 s[30:31], s54, v115
    v_perm_b32 v68, v101, v100, s48
    v_perm_b32 v69, v105, v104, s48
    v_perm_b32 v70, v109, v108, s48
    v_perm_b32 v71, v113, v112, s48
    s_or_b64 s[24:25], s[24:25], s[26:27]
    s_or_b64 s[28:29], s[28:29], s[30:31]
    s_or_b64 s[24:25], s[24:25], s[28:29]
    s_cbranch_scc1 L_fa
L_oka:
    v_perm_b32 v68, v102, v68, s49
    v_perm_b32 v69, v106, v69, s49
    v_perm_b32 v70, v110, v70, s49
    v_perm_b32 v71, v114, v71, s49
    v_mul_f32_dpp v124, v118, v100 quad_perm:[0,0,0,0] row_mask:0xf bank_mask:0xf
    v_mul_f32_dpp v125, v118, v101 quad_perm:[0,0,0,0] row_mask:0xf bank_mask:0xf
    v_mul_f32_dpp v126, v118, v102 quad_perm:[0,0,0,0] row_mask:0xf bank_mask:0xf
    v_mul_f32_dpp v127, v118, v68 quad_perm:[0,0,0,0] row_mask:0xf bank_mask:0xf
    v_fmac_f32_dpp v124, v118, v104 quad_perm:[1,1,1,1] row_mask:0xf bank_mask:0xf
    v_fmac_f32_dpp v125, v118, v105 quad_perm:[1,1,1,1] row_mask:0xf bank_mask:0xf
    v_fmac_f32_dpp v126, v118, v106 quad_perm:[1,1,1,1] row_mask:0xf bank_mask:0xf
    v_fmac_f32_dpp v127, v118, v69 quad_perm:[1,1,1,1] row_mask:0xf bank_mask:0xf
    v_fmac_f32_dpp v124, v118, v108 quad_perm:[2,2,2,2] row_mask:0xf bank_mask:0xf
    v_fmac_f32_dpp v125, v118, v109 quad_perm:[2,2,2,2] row_mask:0xf bank_mask:0xf
    v_fmac_f32_dpp v126, v118, v110 quad_perm:[2,2,2,2] row_mask:0xf bank_mask:0xf
    v_fmac_f32_dpp v127, v118, v70 quad_perm:[2,2,2,2] row_mask:0xf bank_mask:0xf
    v_fmac_f32_dpp v124, v118, v112 quad_perm:[3,3,3,3] row_mask:0xf bank_mask:0xf
    v_fmac_f32_dpp v125, v118, v113 quad_perm:[3,3,3,3] row_mask:0xf bank_mask:0xf
    v_fmac_f32_dpp v126, v118, v114 quad_perm:[3,3,3,3] row_mask:0xf bank_mask:0xf
    v_fmac_f32_dpp v127, v118, v71 quad_perm:[3,3,3,3] row_mask:0xf bank_mask:0xf
    s_nop 0
    v_permlane32_swap_b32 v124, v125
    v_permlane32_swap_b32 v126, v127
    v_add_f32 v124, v124, v125
    v_add_f32 v126, v126, v127
    s_nop 1
    v_permlane16_swap_b32 v124, v126
    v_add_f32 v124, v124, v126
    s_nop 1
    v_add_f32_dpp v124, v124, v124 row_ror:8 row_mask:0xf bank_mask:0xf
    v_add_f32 v124, v124, v50
    s_mov_b64 exec, s[92:93]
    v_cvt_pk_bf16_f32 v124, v124, v124
    buffer_store_short v124, v49, s[40:43], s58 offen
L_done:
    s_barrier
    s_cmp_eq_u64 s[90:91], 0
    s_cbranch_scc1 L_end
    s_waitcnt vmcnt(0)
    buffer_wbl2 sc1
    s_waitcnt vmcnt(0)
    s_branch L_end
L_fa:
    buffer_load_dwordx4 v[100:103], v47, s[36:39], s56 offen offset:0 sc1
    buffer_load_dwordx4 v[104:107], v47, s[36:39], s56 offen offset:1024 sc1
    buffer_load_dwordx4 v[108:111], v47, s[36:39], s56 offen offset:2048 sc1
    buffer_load_dwordx4 v[112:115], v47, s[36:39], s56 offen offset:3072 sc1
    s_waitcnt vmcnt(4)
    v_cmp_ne_u32 s[24:25], s54, v87
    v_cmp_ne_u32 s[26:27], s54, v91
    v_cmp_ne_u32 s[28:29], s54, v95
    v_cmp_ne_u32 s[30:31], s54, v99
    v_perm_b32 v68, v85, v84, s48
    v_perm_b32 v69, v89, v88, s48
    v_perm_b32 v70, v93, v92, s48
    v_perm_b32 v71, v97, v96, s48
    s_or_b64 s[24:25], s[24:25], s[26:27]
    s_or_b64 s[28:29], s[28:29], s[30:31]
    s_or_b64 s[24:25], s[24:25], s[28:29]
    s_cbranch_scc1 L_fb
    v_perm_b32 v68, v86, v68, s49
    v_perm_b32 v69, v90, v69, s49
    v_perm_b32 v70, v94, v70, s49
    v_perm_b32 v71, v98, v71, s49
    v_mul_f32_dpp v124, v118, v84 quad_perm:[0,0,0,0] row_mask:0xf bank_mask:0xf
    v_mul_f32_dpp v125, v118, v85 quad_perm:[0,0,0,0] row_mask:0xf bank_mask:0xf
    v_mul_f32_dpp v126, v118, v86 quad_perm:[0,0,0,0] row_mask:0xf bank_mask:0xf
    v_mul_f32_dpp v127, v118, v68 quad_perm:[0,0,0,0] row_mask:0xf bank_mask:0xf
    v_fmac_f32_dpp v124, v118, v88 quad_perm:[1,1,1,1] row_mask:0xf bank_mask:0xf
    v_fmac_f32_dpp v125, v118, v89 quad_perm:[1,1,1,1] row_mask:0xf bank_mask:0xf
    v_fmac_f32_dpp v126, v118, v90 quad_perm:[1,1,1,1] row_mask:0xf bank_mask:0xf
    v_fmac_f32_dpp v127, v118, v69 quad_perm:[1,1,1,1] row_mask:0xf bank_mask:0xf
    v_fmac_f32_dpp v124, v118, v92 quad_perm:[2,2,2,2] row_mask:0xf bank_mask:0xf
    v_fmac_f32_dpp v125, v118, v93 quad_perm:[2,2,2,2] row_mask:0xf bank_mask:0xf
    v_fmac_f32_dpp v126, v118, v94 quad_perm:[2,2,2,2] row_mask:0xf bank_mask:0xf
    v_fmac_f32_dpp v127, v118, v70 quad_perm:[2,2,2,2] row_mask:0xf bank_mask:0xf
    v_fmac_f32_dpp v124, v118, v96 quad_perm:[3,3,3,3] row_mask:0xf bank_mask:0xf
    v_fmac_f32_dpp v125, v118, v97 quad_perm:[3,3,3,3] row_mask:0xf bank_mask:0xf
    v_fmac_f32_dpp v126, v118, v98 quad_perm:[3,3,3,3] row_mask:0xf bank_mask:0xf
    v_fmac_f32_dpp v127, v118, v71 quad_perm:[3,3,3,3] row_mask:0xf bank_mask:0xf
    s_nop 0
    v_permlane32_swap_b32 v124, v125
    v_permlane32_swap_b32 v126, v127
    v_add_f32 v124, v124, v125
    v_add_f32 v126, v126, v127
    s_nop 1
    v_permlane16_swap_b32 v124, v126
    v_add_f32 v124, v124, v126
    s_nop 1
    v_add_f32_dpp v124, v124, v124 row_ror:8 row_mask:0xf bank_mask:0xf
    v_add_f32 v124, v124, v50
    s_mov_b64 exec, s[92:93]
    v_cvt_pk_bf16_f32 v124, v124, v124
    buffer_store_short v124, v49, s[40:43], s58 offen
    s_branch L_done
L_fb:
    buffer_load_dwordx4 v[84:87], v47, s[36:39], s56 offen offset:0 sc1
    buffer_load_dwordx4 v[88:91], v47, s[36:39], s56 offen offset:1024 sc1
    buffer_load_dwordx4 v[92:95], v47, s[36:39], s56 offen offset:2048 sc1
    buffer_load_dwordx4 v[96:99], v47, s[36:39], s56 offen offset:3072 sc1
    s_add_u32 s59, s59, 1
    s_cmp_lt_u32 s59, 2000000
    s_cbranch_scc1 L_pa
    s_waitcnt vmcnt(0)
    s_branch L_oka
L_mlpoll:
    buffer_load_dwordx4 v[156:159], v48, s[36:39], s57 offen sc1
    s_add_u32 s59, s59, 1
    s_waitcnt vmcnt(0)
    v_cmp_ne_u64 vcc, s[54:55], v[158:159]
    s_cmp_lt_u32 s59, 2000000
    s_cselect_b64 vcc, vcc, 0
    s_nop 0
    s_cbranch_vccnz L_mlpoll
    buffer_load_dwordx4 v[100:103], v47, s[36:39], s56 offen offset:0 sc1
    buffer_load_dwordx4 v[104:107], v47, s[36:39], s56 offen offset:1024 sc1
    buffer_load_dwordx4 v[108:111], v47, s[36:39], s56 offen offset:2048 sc1
    buffer_load_dwordx4 v[112:115], v47, s[36:39], s56 offen offset:3072 sc1
    s_branch L_mlok
L_non:
    s_sleep 8
    buffer_load_dwordx4 v[32:35], off, s[44:47], s87 sc1
    s_waitcnt vmcnt(0)
    v_cmp_eq_u32 vcc, 0, v34
    s_add_u32 s59, s59, 1
    s_cmp_lt_u32 s59, 2000000
    s_cselect_b64 vcc, vcc, 0
    s_nop 0
    s_cbranch_vccnz L_non
    s_branch L_nonok
L_far1:
    buffer_store_dwordx4 v[152:155], v38, s[36:39], s69 offen sc1
    s_branch L_back1
L_far2:
    buffer_store_dwordx4 v[148:151], v36, s[36:39], s68 offen sc1
    s_branch L_back2
L_side:
    s_waitcnt vmcnt(0)
    s_barrier
L_fin:
L_end:
    s_endpgm
.section .rodata,"a"
.p2align 6
.amdhsa_kernel standalone__tree_speculative_verify_tree_attention_over_candidate_token_tree__decode_kernel
  .amdhsa_next_free_vgpr 208
  .amdhsa_next_free_sgpr 96
  .amdhsa_accum_offset 208
  .amdhsa_group_segment_fixed_size 0
  .amdhsa_kernarg_size 72
  .amdhsa_user_sgpr_count 2
  .amdhsa_user_sgpr_kernarg_segment_ptr 1
  .amdhsa_system_sgpr_workgroup_id_x 1
  .amdhsa_float_denorm_mode_32 3
.end_amdhsa_kernel
```
